```python
import torch

def _softmax(x, axis=-1):
    return torch.softmax(x, dim=axis)
def _gelu(x):
    return torch.nn.functional.gelu(x, approximate="tanh")
def _silu(x):
    return torch.nn.functional.silu(x)
def _sigmoid(x):
    return torch.sigmoid(x)
def _layernorm(x, axis=-1, eps=1e-5):
    m = x.mean(dim=axis, keepdim=True)
    v = x.var(dim=axis, keepdim=True, unbiased=False)
    return (x - m) / torch.sqrt(v + eps)
def _scatter_add(tgt, idx, src, axis=0):
    return tgt.clone().index_add_(axis, idx, src)
def _segment_sum(src, seg, n):
    out = torch.zeros((n,) + src.shape[1:], dtype=src.dtype)
    return out.index_add_(0, seg, src)
def _pad(x, pw):
    flat = tuple(v for pair in reversed(pw) for v in pair)
    return torch.nn.functional.pad(x, flat)

kernel_name = 'standalone__dcn_v2_cross__recsys'

def setup_inputs():

    _w = (lambda a: (lambda t: t.to(torch.bfloat16) if t.is_floating_point() else t)(torch.as_tensor(a)))
    B, F, D, L = 1024, 26, 32, 6
    Din = min(F * D, 1024)
    return {
        "x0": _w((lambda *s: torch.randn(*s, dtype=torch.bfloat16) * 0.05)(B, Din)),
        "ws": _w((lambda *s: torch.randn(*s, dtype=torch.bfloat16) * 0.05)(L, Din, Din)),
        "bs": _w((lambda *s: torch.randn(*s, dtype=torch.bfloat16) * 0.05)(L, Din)),
    }

def reference(x0, ws, bs):
    x = x0
    for l in range(ws.shape[0]):
        x = x0 * (x @ ws[l] + bs[l]) + x
    return x
```

```asm
; @launch grid=(256,1,1) block=(512,1,1) lds=147520
.amdgcn_target "amdgcn-amd-amdhsa--gfx950"
.text
.globl standalone__dcn_v2_cross__recsys_kernel
.p2align 8
.type standalone__dcn_v2_cross__recsys_kernel,@function
standalone__dcn_v2_cross__recsys_kernel:

    s_cmp_ge_u32 s2, 256
    s_cbranch_scc1 L_end
    s_load_dwordx4 s[40:43], s[0:1], 0
    s_load_dwordx4 s[44:47], s[0:1], 16
    s_load_dwordx2 s[50:51], s[0:1], 40
    s_getreg_b32 s35, hwreg(HW_REG_XCC_ID, 0, 4)

    s_and_b32 s58, s2, 7
    s_lshr_b32 s59, s2, 3
    s_cmp_ge_u32 s59, 13
    s_cselect_b32 s30, 1, 0
    s_mul_i32 s63, s30, 13
    s_sub_u32 s29, s59, s63
    s_lshl_b32 s28, s58, 1
    s_add_u32 s28, s28, s30

    v_lshrrev_b32 v1, 6, v0
    v_and_b32 v0, 63, v0
    v_readfirstlane_b32 s31, v1
    s_mov_b32 s67, 0
    v_mov_b32 v23, 0
    s_lshl_b32 s71, s28, 12
    s_add_u32 s71, s71, 3407872
    s_and_b32 s32, s31, 1
    s_bfe_u32 s33, s31, 0x10001
    s_sub_u32 s55, s31, 4
    v_lshrrev_b32 v1, 3, v0
    v_and_b32 v2, 7, v0
    v_lshrrev_b32 v3, 1, v1
    v_xor_b32 v2, v2, v3
    v_xor_b32 v3, 4, v2
    v_mul_u32_u24 v1, 1664, v1
    v_lshl_add_u32 v6, v2, 4, v1
    v_lshl_add_u32 v7, v3, 4, v1
    s_lshl_b32 s58, s28, 6
    s_lshl_b32 s59, s32, 5
    s_add_u32 s58, s58, s59
    s_mul_i32 s64, s58, 1664
    s_mul_i32 s59, s33, 768
    s_add_u32 s64, s64, s59
    s_mul_i32 s65, s55, 28672
    s_add_u32 s65, s65, 24576
    s_cmp_ge_u32 s29, 7
    s_cselect_b32 s61, 7, 0
    s_sub_u32 s61, s29, s61
    s_mov_b32 s66, 0
    s_waitcnt lgkmcnt(0)

    s_mov_b32 s12, s40
    s_and_b32 s13, s41, 0xffff
    s_mov_b32 s14, 1703936
    s_mov_b32 s15, 0x20000

    s_cmp_ge_u32 s2, 208
    s_cbranch_scc1 L_nonloader
    s_cmp_lt_u32 s31, 4
    s_cbranch_scc1 L_nonloader

L_xs:
    s_lshl_b32 s58, s61, 12
    s_add_u32 s58, s58, s65
    s_lshl_b32 s59, s61, 7
    s_add_u32 s59, s59, s64

    s_add_u32 m0, s58, 0
    s_add_u32 s60, s59, 0
    buffer_load_dwordx4 v6, s[12:15], s60 offen lds
    s_add_u32 m0, s58, 1024
    s_add_u32 s60, s59, 13312
    buffer_load_dwordx4 v7, s[12:15], s60 offen lds
    s_add_u32 m0, s58, 2048
    s_add_u32 s60, s59, 26624
    buffer_load_dwordx4 v6, s[12:15], s60 offen lds
    s_add_u32 m0, s58, 3072
    s_add_u32 s60, s59, 39936
    buffer_load_dwordx4 v7, s[12:15], s60 offen lds

    s_add_u32 s61, s61, 1
    s_cmp_eq_u32 s61, 7
    s_cselect_b32 s61, 0, s61
    s_add_u32 s66, s66, 1
    s_cmp_lt_u32 s66, 7
    s_cbranch_scc1 L_xs

    s_mov_b32 s4, s42
    s_and_b32 s5, s43, 0xffff
    s_mov_b32 s6, 8306688
    s_mov_b32 s7, 0x20000
    s_mov_b32 s8, s50
    s_and_b32 s9, s51, 0xffff
    s_mov_b32 s10, 3997696
    s_mov_b32 s11, 0x20000
    s_getpc_b64 s[20:21]
L_pc1:
    s_lshr_b32 s22, s2, 3
    s_lshl_b32 s22, s22, 3
    s_add_u32 s22, s22, s31
    s_lshl_b32 s22, s22, 6
    s_sub_u32 s20, s20, L_pc1 - standalone__dcn_v2_cross__recsys_kernel
    s_subb_u32 s21, s21, 0
    s_min_u32 s22, s22, L_end - standalone__dcn_v2_cross__recsys_kernel
    s_load_dword s3, s[20:21], s22
    v_lshrrev_b32 v1, 3, v0
    v_and_b32 v2, 7, v0
    v_bfe_u32 v3, v0, 4, 1
    v_lshlrev_b32 v3, 2, v3
    v_xor_b32 v2, v2, v3
    v_lshlrev_b32 v2, 4, v2
    s_lshl_b32 s58, s29, 7
    v_add_u32 v2, s58, v2
    v_mul_u32_u24 v3, 1664, v1
    v_add_u32 v14, v3, v2
    v_and_b32 v3, 3, v1
    v_lshrrev_b32 v1, 2, v1
    v_lshl_add_u32 v1, v1, 3, v3
    v_mul_u32_u24 v1, 1664, v1
    v_add_u32 v252, v1, v2

    s_mul_i32 s58, s33, 416
    s_lshl_b32 s59, s32, 2
    s_add_u32 s59, s59, s58
    s_mul_i32 s59, s59, 1664
    v_add_u32 v252, s59, v252
    s_lshl_b32 s59, s32, 3
    s_add_u32 s59, s59, s58
    s_mul_i32 s59, s59, 1664
    v_add_u32 v14, s59, v14
    s_mul_i32 s20, s63, 26624
    s_mul_i32 s21, s33, 12288
    s_lshl_b32 s59, s32, 10
    s_add_u32 s21, s21, s59

    s_add_u32 m0, s21, 0
    s_add_u32 s58, s20, 0
    buffer_load_dwordx4 v252, s[4:7], s58 offen lds
    s_add_u32 m0, s21, 2048
    s_add_u32 s58, s20, 26624
    buffer_load_dwordx4 v252, s[4:7], s58 offen lds
    s_add_u32 m0, s21, 4096
    s_add_u32 s58, s20, 53248
    buffer_load_dwordx4 v252, s[4:7], s58 offen lds
    s_add_u32 m0, s21, 6144
    s_add_u32 s58, s20, 79872
    buffer_load_dwordx4 v252, s[4:7], s58 offen lds
    s_add_u32 m0, s21, 8192
    s_add_u32 s58, s20, 106496
    buffer_load_dwordx4 v252, s[4:7], s58 offen lds
    s_add_u32 m0, s21, 10240
    s_add_u32 s58, s20, 133120
    buffer_load_dwordx4 v252, s[4:7], s58 offen lds

    s_mul_i32 s60, s33, 40960
    s_lshl_b32 s59, s32, 10
    s_add_u32 s60, s60, s59
    s_add_u32 s53, s60, 24576
    s_mul_i32 s70, s33, 12288
    s_add_u32 s70, s70, s59
    s_add_u32 s70, s70, 106496
    s_mov_b32 s71, 106496
    s_mul_i32 s58, s33, 416
    s_lshl_b32 s59, s63, 4
    s_add_u32 s58, s58, s59
    s_mul_i32 s59, s32, 21
    s_add_u32 s58, s58, s59
    s_add_u32 s58, s58, 48
    s_mul_i32 s58, s58, 1664
    s_lshl_b32 s59, s29, 7
    s_add_u32 s58, s58, s59
    s_add_u32 s58, s58, 1384448
    s_mov_b32 s98, s42
    s_mov_b32 s99, s43
    s_add_u32 s40, s42, s58
    s_addc_u32 s41, s43, 0
    s_add_u32 s42, s40, 1384448
    s_addc_u32 s43, s41, 0

    s_waitcnt vmcnt(6)

    s_barrier
    s_barrier

    s_load_dwordx2 s[76:77], s[40:41], 60
    s_load_dwordx2 s[78:79], s[40:41], 1724
    s_load_dwordx2 s[80:81], s[40:41], 3388
    s_load_dwordx2 s[82:83], s[40:41], 5052
    s_load_dwordx2 s[84:85], s[40:41], 6716
    s_load_dwordx2 s[86:87], s[40:41], 8380
    s_load_dwordx2 s[88:89], s[40:41], 10044
    s_mul_i32 s64, s63, 26624
    s_add_u32 s64, s64, 0
    s_sub_u32 s65, 13, s63
    s_mul_i32 s65, s65, 26624
    s_add_u32 s65, s65, 0
    s_add_u32 m0, s53, 0
    s_add_u32 s66, s64, 159744
    buffer_load_dwordx4 v252, s[4:7], s66 offen lds
    s_add_u32 m0, s53, 2048
    s_add_u32 s66, s64, 186368
    buffer_load_dwordx4 v252, s[4:7], s66 offen lds
    s_add_u32 m0, s53, 4096
    s_add_u32 s66, s64, 212992
    buffer_load_dwordx4 v252, s[4:7], s66 offen lds
    s_add_u32 m0, s53, 6144
    s_add_u32 s66, s64, 239616
    buffer_load_dwordx4 v252, s[4:7], s66 offen lds
    s_add_u32 m0, s53, 8192
    s_add_u32 s66, s64, 266240
    buffer_load_dwordx4 v252, s[4:7], s66 offen lds
    s_add_u32 m0, s53, 10240
    s_add_u32 s66, s64, 292864
    buffer_load_dwordx4 v252, s[4:7], s66 offen lds
    s_add_u32 m0, s53, 12288
    s_add_u32 s66, s64, 319488
    buffer_load_dwordx4 v252, s[4:7], s66 offen lds
    s_waitcnt vmcnt(7)
    s_barrier
    s_add_u32 m0, s53, 14336
    s_add_u32 s66, s65, 0
    buffer_load_dwordx4 v252, s[4:7], s66 offen lds
    s_add_u32 m0, s53, 16384
    s_add_u32 s66, s65, 26624
    buffer_load_dwordx4 v252, s[4:7], s66 offen lds
    s_add_u32 m0, s53, 18432
    s_add_u32 s66, s65, 53248
    buffer_load_dwordx4 v252, s[4:7], s66 offen lds
    s_add_u32 m0, s53, 20480
    s_add_u32 s66, s65, 79872
    buffer_load_dwordx4 v252, s[4:7], s66 offen lds
    s_add_u32 m0, s53, 22528
    s_add_u32 s66, s65, 106496
    buffer_load_dwordx4 v252, s[4:7], s66 offen lds
    s_add_u32 m0, s53, 24576
    s_add_u32 s66, s65, 133120
    buffer_load_dwordx4 v252, s[4:7], s66 offen lds
    s_add_u32 m0, s53, 26624
    s_add_u32 s66, s65, 159744
    buffer_load_dwordx4 v252, s[4:7], s66 offen lds
    s_add_u32 m0, s53, 28672
    s_add_u32 s66, s65, 186368
    buffer_load_dwordx4 v252, s[4:7], s66 offen lds
    s_add_u32 m0, s53, 30720
    s_add_u32 s66, s65, 212992
    buffer_load_dwordx4 v252, s[4:7], s66 offen lds
    s_add_u32 m0, s53, 32768
    s_add_u32 s66, s65, 239616
    buffer_load_dwordx4 v252, s[4:7], s66 offen lds
    s_add_u32 m0, s53, 34816
    s_add_u32 s66, s65, 266240
    buffer_load_dwordx4 v252, s[4:7], s66 offen lds
    s_add_u32 m0, s53, 36864
    s_add_u32 s66, s65, 292864
    buffer_load_dwordx4 v252, s[4:7], s66 offen lds
    s_add_u32 m0, s53, 38912
    s_add_u32 s66, s65, 319488
    buffer_load_dwordx4 v252, s[4:7], s66 offen lds
    s_waitcnt lgkmcnt(0)
    s_load_dwordx2 s[76:77], s[40:41], 11708
    s_load_dwordx2 s[78:79], s[40:41], 13372
    s_load_dwordx2 s[80:81], s[40:41], 15036
    s_load_dwordx2 s[82:83], s[40:41], 16700
    s_load_dwordx2 s[84:85], s[40:41], 18364
    s_load_dwordx2 s[86:87], s[40:41], 20028
    s_load_dwordx2 s[88:89], s[40:41], 21692
    s_waitcnt vmcnt(13)
    s_barrier
    s_waitcnt vmcnt(9)
    s_barrier
    s_waitcnt vmcnt(6)
    s_barrier
    s_waitcnt vmcnt(3)
    s_barrier
    s_waitcnt vmcnt(0)
    s_barrier
    s_barrier
    s_mov_b32 s61, 1384448
    s_mul_i32 s64, s63, 26624
    s_add_u32 s64, s64, s61
    s_add_u32 m0, s70, 0
    s_add_u32 s66, s64, 0
    buffer_load_dwordx4 v14, s[4:7], s66 offen lds
    s_add_u32 m0, s70, 2048
    s_add_u32 s66, s64, 26624
    buffer_load_dwordx4 v14, s[4:7], s66 offen lds
    s_add_u32 m0, s70, 4096
    s_add_u32 s66, s64, 53248
    buffer_load_dwordx4 v14, s[4:7], s66 offen lds
    s_add_u32 m0, s70, 6144
    s_add_u32 s66, s64, 79872
    buffer_load_dwordx4 v14, s[4:7], s66 offen lds
    s_add_u32 m0, s70, 8192
    s_add_u32 s66, s64, 106496
    buffer_load_dwordx4 v14, s[4:7], s66 offen lds
    s_add_u32 m0, s70, 10240
    s_add_u32 s66, s64, 133120
    buffer_load_dwordx4 v14, s[4:7], s66 offen lds
    s_sub_u32 s70, s70, s71
    s_sub_u32 s71, 0, s71
    s_add_u32 s40, s40, 1384448
    s_addc_u32 s41, s41, 0
    s_add_u32 s42, s42, 1384448
    s_addc_u32 s43, s43, 0

    s_barrier
    s_mov_b32 s34, 1
    s_mov_b32 s61, 1384448
L_ld_layer:
    s_cmp_lt_u32 s34, 5
    s_cselect_b32 s55, 1, 0

    s_cmp_eq_u32 s55, 1
    s_cbranch_scc0 L_sA
    s_load_dwordx2 s[76:77], s[40:41], 11708
    s_load_dwordx2 s[78:79], s[40:41], 13372
    s_load_dwordx2 s[80:81], s[40:41], 15036
    s_load_dwordx2 s[82:83], s[40:41], 16700
    s_load_dwordx2 s[84:85], s[40:41], 18364
    s_load_dwordx2 s[86:87], s[40:41], 20028
    s_load_dwordx2 s[88:89], s[40:41], 21692
L_sA:
    s_mul_i32 s64, s63, 26624
    s_add_u32 s64, s64, s61
    s_sub_u32 s65, 13, s63
    s_mul_i32 s65, s65, 26624
    s_add_u32 s65, s65, s61
    s_barrier
    s_add_u32 m0, s53, 0
    s_add_u32 s66, s64, 159744
    buffer_load_dwordx4 v14, s[4:7], s66 offen lds
    s_add_u32 m0, s53, 2048
    s_add_u32 s66, s64, 186368
    buffer_load_dwordx4 v14, s[4:7], s66 offen lds
    s_add_u32 m0, s53, 4096
    s_add_u32 s66, s64, 212992
    buffer_load_dwordx4 v14, s[4:7], s66 offen lds
    s_add_u32 m0, s53, 6144
    s_add_u32 s66, s64, 239616
    buffer_load_dwordx4 v14, s[4:7], s66 offen lds
    s_barrier
    s_add_u32 m0, s53, 8192
    s_add_u32 s66, s64, 266240
    buffer_load_dwordx4 v14, s[4:7], s66 offen lds
    s_add_u32 m0, s53, 10240
    s_add_u32 s66, s64, 292864
    buffer_load_dwordx4 v14, s[4:7], s66 offen lds
    s_add_u32 m0, s53, 12288
    s_add_u32 s66, s64, 319488
    buffer_load_dwordx4 v14, s[4:7], s66 offen lds
    s_add_u32 m0, s53, 14336
    s_add_u32 s66, s65, 0
    buffer_load_dwordx4 v14, s[4:7], s66 offen lds
    s_add_u32 m0, s53, 16384
    s_add_u32 s66, s65, 26624
    buffer_load_dwordx4 v14, s[4:7], s66 offen lds
    s_add_u32 m0, s53, 18432
    s_add_u32 s66, s65, 53248
    buffer_load_dwordx4 v14, s[4:7], s66 offen lds
    s_add_u32 m0, s53, 20480
    s_add_u32 s66, s65, 79872
    buffer_load_dwordx4 v14, s[4:7], s66 offen lds
    s_add_u32 m0, s53, 22528
    s_add_u32 s66, s65, 106496
    buffer_load_dwordx4 v14, s[4:7], s66 offen lds
    s_add_u32 m0, s53, 24576
    s_add_u32 s66, s65, 133120
    buffer_load_dwordx4 v14, s[4:7], s66 offen lds
    s_add_u32 m0, s53, 26624
    s_add_u32 s66, s65, 159744
    buffer_load_dwordx4 v14, s[4:7], s66 offen lds
    s_add_u32 m0, s53, 28672
    s_add_u32 s66, s65, 186368
    buffer_load_dwordx4 v14, s[4:7], s66 offen lds
    s_add_u32 m0, s53, 30720
    s_add_u32 s66, s65, 212992
    buffer_load_dwordx4 v14, s[4:7], s66 offen lds
    s_add_u32 m0, s53, 32768
    s_add_u32 s66, s65, 239616
    buffer_load_dwordx4 v14, s[4:7], s66 offen lds
    s_add_u32 m0, s53, 34816
    s_add_u32 s66, s65, 266240
    buffer_load_dwordx4 v14, s[4:7], s66 offen lds
    s_add_u32 m0, s53, 36864
    s_add_u32 s66, s65, 292864
    buffer_load_dwordx4 v14, s[4:7], s66 offen lds
    s_add_u32 m0, s53, 38912
    s_add_u32 s66, s65, 319488
    buffer_load_dwordx4 v14, s[4:7], s66 offen lds
    s_cmp_eq_u32 s55, 1
    s_cbranch_scc0 L_sB
    s_waitcnt lgkmcnt(0)
    s_load_dwordx2 s[76:77], s[40:41], 23356
    s_load_dwordx2 s[78:79], s[40:41], 25020
    s_load_dwordx2 s[80:81], s[40:41], 26684
    s_load_dwordx2 s[82:83], s[40:41], 28348
    s_load_dwordx2 s[84:85], s[40:41], 30012
    s_load_dwordx2 s[86:87], s[40:41], 31676
    s_load_dwordx2 s[88:89], s[40:41], 33340
L_sB:
    s_waitcnt vmcnt(20)
    s_barrier
    s_waitcnt vmcnt(0)
    s_barrier
    s_cmp_lt_u32 s34, 4
    s_cselect_b32 s55, 1, 0
    s_cmp_eq_u32 s55, 1
    s_cbranch_scc0 L_sC
    s_waitcnt lgkmcnt(0)
    s_load_dwordx2 s[76:77], s[42:43], 60
    s_load_dwordx2 s[78:79], s[42:43], 1724
    s_load_dwordx2 s[80:81], s[42:43], 3388
    s_load_dwordx2 s[82:83], s[42:43], 5052
    s_load_dwordx2 s[84:85], s[42:43], 6716
    s_load_dwordx2 s[86:87], s[42:43], 8380
    s_load_dwordx2 s[88:89], s[42:43], 10044
L_sC:
    s_barrier
    s_cmp_lt_u32 s34, 5
    s_cbranch_scc0 L_nopre
    s_add_u32 s55, s61, 1384448
    s_mul_i32 s64, s63, 26624
    s_add_u32 s64, s64, s55
    s_add_u32 m0, s70, 0
    s_add_u32 s66, s64, 0
    buffer_load_dwordx4 v14, s[4:7], s66 offen lds
    s_add_u32 m0, s70, 2048
    s_add_u32 s66, s64, 26624
    buffer_load_dwordx4 v14, s[4:7], s66 offen lds
    s_add_u32 m0, s70, 4096
    s_add_u32 s66, s64, 53248
    buffer_load_dwordx4 v14, s[4:7], s66 offen lds
    s_add_u32 m0, s70, 6144
    s_add_u32 s66, s64, 79872
    buffer_load_dwordx4 v14, s[4:7], s66 offen lds
    s_add_u32 m0, s70, 8192
    s_add_u32 s66, s64, 106496
    buffer_load_dwordx4 v14, s[4:7], s66 offen lds
    s_add_u32 m0, s70, 10240
    s_add_u32 s66, s64, 133120
    buffer_load_dwordx4 v14, s[4:7], s66 offen lds
    s_sub_u32 s70, s70, s71
    s_sub_u32 s71, 0, s71
L_nopre:
    s_add_u32 s40, s40, 1384448
    s_addc_u32 s41, s41, 0
    s_add_u32 s42, s42, 1384448
    s_addc_u32 s43, s43, 0

    s_barrier
    s_add_u32 s34, s34, 1
    s_add_u32 s61, s61, 1384448
    s_cmp_lt_u32 s34, 6
    s_cbranch_scc1 L_ld_layer

    s_endpgm
L_nonloader:
    s_mov_b32 s4, s42
    s_and_b32 s5, s43, 0xffff
    s_mov_b32 s6, 8306688
    s_mov_b32 s7, 0x20000
    s_mov_b32 s8, s50
    s_and_b32 s9, s51, 0xffff
    s_mov_b32 s10, 3997696
    s_mov_b32 s11, 0x20000
    s_getpc_b64 s[20:21]
L_pc2:
    s_lshr_b32 s22, s2, 3
    s_lshl_b32 s22, s22, 3
    s_add_u32 s22, s22, s31
    s_lshl_b32 s22, s22, 6
    s_sub_u32 s20, s20, L_pc2 - standalone__dcn_v2_cross__recsys_kernel
    s_subb_u32 s21, s21, 0
    s_min_u32 s22, s22, L_end - standalone__dcn_v2_cross__recsys_kernel
    s_load_dword s3, s[20:21], s22

    s_cmp_ge_u32 s2, 208
    s_cbranch_scc1 L_helper

L_compute:
    s_load_dwordx2 s[72:73], s[50:51], s71
    s_lshl_b32 s58, s29, 7
    s_lshl_b32 s59, s33, 6
    s_add_u32 s58, s58, s59
    s_add_u32 s48, s44, s58
    s_addc_u32 s49, s45, 0
    s_load_dwordx16 s[84:99], s[48:49], 0
    s_load_dword s20, s[48:49], 1664
    s_load_dword s21, s[48:49], 3328
    s_load_dword s22, s[48:49], 4992
    s_load_dword s23, s[48:49], 6656
    s_load_dword s24, s[48:49], 8320
    s_add_u32 s48, s48, 1664
    s_addc_u32 s49, s49, 0

    v_min_u32 v1, 51, v0
    v_lshlrev_b32 v1, 3, v1
    s_add_u32 s58, s71, 2048
    v_add_u32 v15, s58, v1
    s_cmp_eq_u32 s31, 0
    s_cbranch_scc0 L_noft
    buffer_load_dword v5, v15, s[8:11], 0 offen sc1
L_noft:
    s_lshl_b32 s59, s29, 2
    s_add_u32 s59, s59, s31
    s_lshl_b32 s59, s59, 3
    s_add_u32 s56, s58, s59
    v_min_u32 v1, 12, v0
    v_lshlrev_b32 v1, 3, v1
    s_add_u32 s58, s71, 128
    v_add_u32 v249, s58, v1

    s_mov_b32 s16, s46
    s_and_b32 s17, s47, 0xffff
    s_mov_b32 s18, 1703936
    s_mov_b32 s19, 0x20000

    s_lshl_b32 s58, s28, 6
    s_lshl_b32 s59, s32, 5
    s_add_u32 s58, s58, s59
    s_mul_i32 s58, s58, 1664
    s_lshl_b32 s59, s29, 7
    s_add_u32 s58, s58, s59
    s_lshl_b32 s59, s33, 6
    s_add_u32 s58, s58, s59
    v_and_b32 v1, 31, v0
    v_mul_u32_u24 v1, 1664, v1
    v_lshrrev_b32 v2, 5, v0
    v_lshl_add_u32 v1, v2, 4, v1
    v_add_u32 v248, s58, v1
    v_lshlrev_b32 v6, 4, v0
    v_add_u32 v7, 0x1000, v6
    v_add_u32 v8, 0x2000, v6
    v_add_u32 v9, 0x3000, v6
    s_mul_i32 s58, s28, 106496
    s_mul_i32 s59, s32, 53248
    s_add_u32 s58, s58, s59
    s_add_u32 s58, s58, 1703936
    s_lshl_b32 s59, s29, 2
    s_lshl_b32 s60, s33, 1
    s_add_u32 s59, s59, s60
    s_lshl_b32 s59, s59, 10
    s_add_u32 s39, s58, s59

    s_mul_i32 s59, s33, 26
    s_add_u32 s60, s59, s63
    s_lshl_b32 s60, s60, 10
    s_add_u32 s37, s58, s60
    s_add_u32 s60, s59, 13
    s_sub_u32 s60, s60, s63
    s_lshl_b32 s60, s60, 10
    s_add_u32 s38, s58, s60
    s_mov_b32 s70, 4293263360
    s_mov_b32 s57, 4293263360
    s_mul_i32 s58, s33, 416
    s_lshl_b32 s59, s63, 4
    s_add_u32 s58, s58, s59
    s_lshl_b32 s59, s32, 3
    s_add_u32 s58, s58, s59
    s_mul_i32 s52, s58, 1664
    s_add_u32 s52, s52, 1384448
    s_mul_i32 s53, s33, 12288
    s_lshl_b32 s59, s32, 10
    s_add_u32 s53, s53, s59
    s_add_u32 s53, s53, 106496
    s_mov_b32 s54, 106496
    v_lshrrev_b32 v1, 5, v0
    v_lshlrev_b32 v1, 2, v1
    v_bfe_u32 v2, v0, 2, 2
    v_add_u32 v1, v1, v2
    v_lshlrev_b32 v1, 7, v1
    v_bfe_u32 v2, v0, 4, 1
    v_lshlrev_b32 v2, 1, v2
    v_bfe_u32 v3, v0, 1, 1
    v_add_u32 v2, v2, v3
    v_bfe_u32 v3, v0, 3, 1
    v_lshlrev_b32 v3, 2, v3
    v_xor_b32 v2, v2, v3
    v_lshlrev_b32 v2, 4, v2
    v_add_u32 v1, v1, v2
    v_and_b32 v2, 1, v0
    v_lshlrev_b32 v2, 3, v2
    v_add_u32 v1, v1, v2
    s_lshl_b32 s58, s33, 6
    v_xor_b32 v2, s58, v1
    v_xor_b32 v3, 64, v2
    s_mul_i32 s58, s33, 12288
    v_add_u32 v10, s58, v2
    v_add_u32 v11, s58, v3
    s_mul_i32 s58, s33, 40960
    s_add_u32 s58, s58, 24576
    v_add_u32 v12, s58, v2
    v_add_u32 v13, s58, v3
    s_lshl_b32 s58, s31, 12
    s_add_u32 s58, s58, 131072
    v_add_u32 v20, s58, v6
    s_xor_b32 s59, s31, 2
    s_lshl_b32 s59, s59, 12
    s_add_u32 s59, s59, 131072
    v_add_u32 v21, s59, v6
    v_lshrrev_b32 v1, 5, v0
    v_lshlrev_b32 v4, 3, v1
    v_and_b32 v1, 31, v0
    v_lshrrev_b32 v2, 3, v1
    v_lshlrev_b32 v2, 10, v2
    v_and_b32 v3, 7, v1
    v_lshl_add_u32 v2, v3, 7, v2
    v_bfe_u32 v3, v1, 1, 3
    s_cmp_ge_u32 s29, 7
    s_cselect_b32 s58, 1, 0
    s_mul_i32 s59, s58, 6
    s_sub_u32 s59, s29, s59
    s_lshl_b32 s59, s59, 12
    s_lshl_b32 s58, s58, 1
    s_add_u32 s58, s58, s32
    s_mul_i32 s58, s58, 28672
    s_add_u32 s58, s58, s59
    s_add_u32 s58, s58, 24576
    s_lshl_b32 s59, s33, 2
    v_add3_u32 v4, v4, v2, s58
    v_xor_b32 v1, s59, v3

    v_xor_b32 v72, 0, v1
    v_lshl_add_u32 v72, v72, 4, v4
    v_xor_b32 v73, 1, v1
    v_lshl_add_u32 v73, v73, 4, v4
    v_xor_b32 v74, 2, v1
    v_lshl_add_u32 v74, v74, 4, v4
    v_xor_b32 v75, 3, v1
    v_lshl_add_u32 v75, v75, 4, v4

    v_lshrrev_b32 v1, 5, v0
    v_xor_b32 v3, v3, v1
    s_mul_i32 s61, s31, 28672
    s_add_u32 s61, s61, 24576
    s_mul_i32 s66, s33, 26
    s_mul_i32 s65, s33, 6

    s_add_u32 s64, s66, s63
    s_add_u32 s58, s64, 0
    s_and_b32 s59, s58, 3
    s_lshl_b32 s59, s59, 1
    s_lshr_b32 s58, s58, 2
    s_sub_u32 s58, s58, s65
    s_lshl_b32 s58, s58, 12
    s_add_u32 s58, s58, s61
    v_xor_b32 v64, s59, v3
    v_lshl_add_u32 v64, v64, 4, v2
    v_add_u32 v64, s58, v64
    s_add_u32 s58, s64, 1
    s_and_b32 s59, s58, 3
    s_lshl_b32 s59, s59, 1
    s_lshr_b32 s58, s58, 2
    s_sub_u32 s58, s58, s65
    s_lshl_b32 s58, s58, 12
    s_add_u32 s58, s58, s61
    v_xor_b32 v65, s59, v3
    v_lshl_add_u32 v65, v65, 4, v2
    v_add_u32 v65, s58, v65
    s_add_u32 s58, s64, 2
    s_and_b32 s59, s58, 3
    s_lshl_b32 s59, s59, 1
    s_lshr_b32 s58, s58, 2
    s_sub_u32 s58, s58, s65
    s_lshl_b32 s58, s58, 12
    s_add_u32 s58, s58, s61
    v_xor_b32 v66, s59, v3
    v_lshl_add_u32 v66, v66, 4, v2
    v_add_u32 v66, s58, v66
    s_add_u32 s58, s64, 3
    s_and_b32 s59, s58, 3
    s_lshl_b32 s59, s59, 1
    s_lshr_b32 s58, s58, 2
    s_sub_u32 s58, s58, s65
    s_lshl_b32 s58, s58, 12
    s_add_u32 s58, s58, s61
    v_xor_b32 v67, s59, v3
    v_lshl_add_u32 v67, v67, 4, v2
    v_add_u32 v67, s58, v67
    s_add_u32 s64, s66, 13
    s_sub_u32 s64, s64, s63
    s_add_u32 s58, s64, 0
    s_and_b32 s59, s58, 3
    s_lshl_b32 s59, s59, 1
    s_lshr_b32 s58, s58, 2
    s_sub_u32 s58, s58, s65
    s_lshl_b32 s58, s58, 12
    s_add_u32 s58, s58, s61
    v_xor_b32 v68, s59, v3
    v_lshl_add_u32 v68, v68, 4, v2
    v_add_u32 v68, s58, v68
    s_add_u32 s58, s64, 1
    s_and_b32 s59, s58, 3
    s_lshl_b32 s59, s59, 1
    s_lshr_b32 s58, s58, 2
    s_sub_u32 s58, s58, s65
    s_lshl_b32 s58, s58, 12
    s_add_u32 s58, s58, s61
    v_xor_b32 v69, s59, v3
    v_lshl_add_u32 v69, v69, 4, v2
    v_add_u32 v69, s58, v69
    s_add_u32 s58, s64, 2
    s_and_b32 s59, s58, 3
    s_lshl_b32 s59, s59, 1
    s_lshr_b32 s58, s58, 2
    s_sub_u32 s58, s58, s65
    s_lshl_b32 s58, s58, 12
    s_add_u32 s58, s58, s61
    v_xor_b32 v70, s59, v3
    v_lshl_add_u32 v70, v70, 4, v2
    v_add_u32 v70, s58, v70
    s_add_u32 s58, s64, 3
    s_and_b32 s59, s58, 3
    s_lshl_b32 s59, s59, 1
    s_lshr_b32 s58, s58, 2
    s_sub_u32 s58, s58, s65
    s_lshl_b32 s58, s58, 12
    s_add_u32 s58, s58, s61
    v_xor_b32 v71, s59, v3
    v_lshl_add_u32 v71, v71, 4, v2
    v_add_u32 v71, s58, v71

    s_waitcnt lgkmcnt(0)
    s_add_u32 s74, s72, 1
    s_addc_u32 s75, s73, 0
    s_add_u32 s76, s72, 2
    s_addc_u32 s77, s73, 0
    s_cmp_eq_u32 s31, 0
    s_cbranch_scc0 L_nohello
    s_add_u32 s58, s72, 8
    s_addc_u32 s59, s73, 0
    s_lshl_b32 s60, s35, 28
    s_xor_b32 s59, s59, s60
    v_mov_b32 v16, s58
    v_mov_b32 v17, s59
    s_lshl_b32 s60, s29, 3
    s_add_u32 s60, s60, s71
    s_add_u32 s60, s60, 128
    s_mov_b64 exec, 1
    buffer_store_dwordx2 v[16:17], off, s[8:11], s60 sc1
    s_mov_b64 exec, -1
L_nohello:

    s_lshr_b32 s58, s28, 2
    s_mul_i32 s58, s58, 208
    s_and_b32 s59, s28, 3
    s_mul_i32 s59, s59, 12
    s_add_u32 s58, s58, s59
    s_mul_i32 s59, s31, 3
    s_add_u32 s58, s58, s59
    s_mul_i32 s58, s58, 1664
    s_lshl_b32 s59, s29, 7
    s_add_u32 s58, s58, s59
    s_add_u32 s58, s58, 1384448
    s_add_u32 s44, s42, s58
    s_addc_u32 s45, s43, 0

    s_add_u32 s46, s44, 0
    s_addc_u32 s47, s45, 0
    s_load_dwordx2 s[20:21], s[46:47], 60
    s_load_dwordx2 s[22:23], s[46:47], 1724
    s_load_dwordx2 s[20:21], s[46:47], 3388
    s_add_u32 s46, s44, 1384448
    s_addc_u32 s47, s45, 0
    s_load_dwordx2 s[22:23], s[46:47], 60
    s_load_dwordx2 s[20:21], s[46:47], 1724
    s_load_dwordx2 s[22:23], s[46:47], 3388
    s_add_u32 s46, s44, 2768896
    s_addc_u32 s47, s45, 0
    s_load_dwordx2 s[20:21], s[46:47], 60
    s_barrier
    ds_read_b64 v[24:25], v72
    ds_read_b64 v[26:27], v73
    ds_read_b64 v[28:29], v74
    ds_read_b64 v[30:31], v75
    ds_read_b128 v[136:139], v64 offset:0
    ds_read_b128 v[140:143], v65 offset:0
    ds_read_b128 v[144:147], v66 offset:0
    ds_read_b128 v[148:151], v67 offset:0
    ds_read_b128 v[152:155], v64 offset:4096
    ds_read_b128 v[156:159], v65 offset:4096
    ds_read_b128 v[160:163], v66 offset:4096
    ds_read_b128 v[164:167], v67 offset:4096
    ds_read_b128 v[168:171], v64 offset:8192
    ds_read_b128 v[172:175], v65 offset:8192
    s_waitcnt lgkmcnt(6)
    ds_read_b128 v[176:179], v66 offset:8192
    ds_read_b128 v[180:183], v67 offset:8192
    ds_read_b128 v[184:187], v64 offset:12288
    ds_read_b128 v[188:191], v68 offset:0
    ds_read_b128 v[192:195], v69 offset:0
    ds_read_b128 v[196:199], v70 offset:0
    ds_read_b128 v[200:203], v71 offset:0
    ds_read_b128 v[204:207], v68 offset:4096
    s_waitcnt lgkmcnt(6)
    ds_read_b128 v[208:211], v69 offset:4096
    ds_read_b128 v[212:215], v70 offset:4096
    ds_read_b128 v[216:219], v71 offset:4096
    ds_read_b128 v[220:223], v68 offset:8192
    ds_read_b128 v[224:227], v69 offset:8192
    ds_read_b128 v[228:231], v70 offset:8192
    ds_read_b128 v[232:235], v71 offset:8192
    ds_read_b128 v[236:239], v68 offset:12288
    s_waitcnt lgkmcnt(0)
    s_barrier
    s_add_u32 s46, s44, 2768896
    s_addc_u32 s47, s45, 0
    s_load_dwordx2 s[20:21], s[46:47], 1724
    s_load_dwordx2 s[22:23], s[46:47], 3388
    s_add_u32 s46, s44, 4153344
    s_addc_u32 s47, s45, 0
    s_load_dwordx2 s[20:21], s[46:47], 60
    s_load_dwordx2 s[22:23], s[46:47], 1724
    s_load_dwordx2 s[20:21], s[46:47], 3388
    s_add_u32 s46, s44, 5537792
    s_addc_u32 s47, s45, 0
    s_load_dwordx2 s[22:23], s[46:47], 60
    s_load_dwordx2 s[20:21], s[46:47], 1724
    v_lshlrev_b32 v80, 16, v24
    v_and_b32 v81, 0xffff0000, v24
    v_lshlrev_b32 v82, 16, v25
    v_and_b32 v83, 0xffff0000, v25
    v_lshlrev_b32 v84, 16, v26
    v_and_b32 v85, 0xffff0000, v26
    v_lshlrev_b32 v86, 16, v27
    v_and_b32 v87, 0xffff0000, v27
    v_lshlrev_b32 v88, 16, v28
    v_and_b32 v89, 0xffff0000, v28
    v_lshlrev_b32 v90, 16, v29
    v_and_b32 v91, 0xffff0000, v29
    v_lshlrev_b32 v92, 16, v30
    v_and_b32 v93, 0xffff0000, v30
    v_lshlrev_b32 v94, 16, v31
    v_and_b32 v95, 0xffff0000, v31
    s_mov_b32 exec_hi, 0
    v_mov_b32 v240, s84
    v_mov_b32 v241, s85
    v_mov_b32 v242, s88
    v_mov_b32 v243, s89
    v_mov_b32 v244, s92
    v_mov_b32 v245, s93
    v_mov_b32 v246, s96
    v_mov_b32 v247, s97
    s_mov_b32 exec_lo, 0
    s_mov_b32 exec_hi, -1
    v_mov_b32 v240, s86
    v_mov_b32 v241, s87
    v_mov_b32 v242, s90
    v_mov_b32 v243, s91
    v_mov_b32 v244, s94
    v_mov_b32 v245, s95
    v_mov_b32 v246, s98
    v_mov_b32 v247, s99
    s_mov_b64 exec, -1
    v_lshlrev_b32 v32, 16, v240
    v_and_b32 v33, 0xffff0000, v240
    v_lshlrev_b32 v34, 16, v241
    v_and_b32 v35, 0xffff0000, v241
    v_lshlrev_b32 v36, 16, v242
    v_and_b32 v37, 0xffff0000, v242
    v_lshlrev_b32 v38, 16, v243
    v_and_b32 v39, 0xffff0000, v243
    v_lshlrev_b32 v40, 16, v244
    v_and_b32 v41, 0xffff0000, v244
    v_lshlrev_b32 v42, 16, v245
    v_and_b32 v43, 0xffff0000, v245
    v_lshlrev_b32 v44, 16, v246
    v_and_b32 v45, 0xffff0000, v246
    v_lshlrev_b32 v46, 16, v247
    v_and_b32 v47, 0xffff0000, v247
    v_mov_b32 v96, v80
    v_mov_b32 v97, v81
    v_mov_b32 v98, v82
    v_mov_b32 v99, v83
    v_mov_b32 v100, v84
    v_mov_b32 v101, v85
    v_mov_b32 v102, v86
    v_mov_b32 v103, v87
    v_mov_b32 v104, v88
    v_mov_b32 v105, v89
    v_mov_b32 v106, v90
    v_mov_b32 v107, v91
    v_mov_b32 v108, v92
    v_mov_b32 v109, v93
    v_mov_b32 v110, v94
    v_mov_b32 v111, v95
    s_mov_b32 s34, 0
    s_barrier
    ds_read_b64_tr_b16 v[112:113], v11 offset:0
    ds_read_b64_tr_b16 v[114:115], v11 offset:1024
    ds_read_b64_tr_b16 v[116:117], v10 offset:0
    ds_read_b64_tr_b16 v[118:119], v10 offset:1024
    ds_read_b64_tr_b16 v[120:121], v11 offset:2048
    ds_read_b64_tr_b16 v[122:123], v11 offset:3072
    ds_read_b64_tr_b16 v[124:125], v10 offset:2048
    ds_read_b64_tr_b16 v[126:127], v10 offset:3072
    s_waitcnt lgkmcnt(4)
    v_mfma_f32_32x32x16_bf16 v[48:63], v[112:115], v[136:139], 0
    ds_read_b64_tr_b16 v[128:129], v11 offset:4096
    ds_read_b64_tr_b16 v[130:131], v11 offset:5120
    v_mfma_f32_32x32x16_bf16 v[32:47], v[116:119], v[136:139], v[32:47]
    ds_read_b64_tr_b16 v[132:133], v10 offset:4096
    ds_read_b64_tr_b16 v[134:135], v10 offset:5120
    s_waitcnt lgkmcnt(4)
    v_mfma_f32_32x32x16_bf16 v[48:63], v[120:123], v[140:143], v[48:63]
    ds_read_b64_tr_b16 v[112:113], v11 offset:6144
    ds_read_b64_tr_b16 v[114:115], v11 offset:7168
    v_mfma_f32_32x32x16_bf16 v[32:47], v[124:127], v[140:143], v[32:47]
    ds_read_b64_tr_b16 v[116:117], v10 offset:6144
    ds_read_b64_tr_b16 v[118:119], v10 offset:7168
    s_waitcnt lgkmcnt(4)
    v_mfma_f32_32x32x16_bf16 v[48:63], v[128:131], v[144:147], v[48:63]
    ds_read_b64_tr_b16 v[120:121], v11 offset:8192
    ds_read_b64_tr_b16 v[122:123], v11 offset:9216
    v_mfma_f32_32x32x16_bf16 v[32:47], v[132:135], v[144:147], v[32:47]
    ds_read_b64_tr_b16 v[124:125], v10 offset:8192
    ds_read_b64_tr_b16 v[126:127], v10 offset:9216
    s_waitcnt lgkmcnt(4)
    v_mfma_f32_32x32x16_bf16 v[48:63], v[112:115], v[148:151], v[48:63]
    ds_read_b64_tr_b16 v[128:129], v11 offset:10240
    ds_read_b64_tr_b16 v[130:131], v11 offset:11264
    v_mfma_f32_32x32x16_bf16 v[32:47], v[116:119], v[148:151], v[32:47]
    ds_read_b64_tr_b16 v[132:133], v10 offset:10240
    ds_read_b64_tr_b16 v[134:135], v10 offset:11264
    s_waitcnt lgkmcnt(4)
    v_mfma_f32_32x32x16_bf16 v[48:63], v[120:123], v[152:155], v[48:63]
    s_barrier
    ds_read_b64_tr_b16 v[112:113], v13 offset:0
    ds_read_b64_tr_b16 v[114:115], v13 offset:1024
    v_mfma_f32_32x32x16_bf16 v[32:47], v[124:127], v[152:155], v[32:47]
    ds_read_b64_tr_b16 v[116:117], v12 offset:0
    ds_read_b64_tr_b16 v[118:119], v12 offset:1024
    s_waitcnt lgkmcnt(4)
    v_mfma_f32_32x32x16_bf16 v[48:63], v[128:131], v[156:159], v[48:63]
    ds_read_b64_tr_b16 v[120:121], v13 offset:2048
    ds_read_b64_tr_b16 v[122:123], v13 offset:3072
    v_mfma_f32_32x32x16_bf16 v[32:47], v[132:135], v[156:159], v[32:47]
    ds_read_b64_tr_b16 v[124:125], v12 offset:2048
    ds_read_b64_tr_b16 v[126:127], v12 offset:3072
    s_waitcnt lgkmcnt(4)
    v_mfma_f32_32x32x16_bf16 v[48:63], v[112:115], v[160:163], v[48:63]
    ds_read_b64_tr_b16 v[128:129], v13 offset:4096
    ds_read_b64_tr_b16 v[130:131], v13 offset:5120
    v_mfma_f32_32x32x16_bf16 v[32:47], v[116:119], v[160:163], v[32:47]
    ds_read_b64_tr_b16 v[132:133], v12 offset:4096
    ds_read_b64_tr_b16 v[134:135], v12 offset:5120
    s_waitcnt lgkmcnt(4)
    v_mfma_f32_32x32x16_bf16 v[48:63], v[120:123], v[164:167], v[48:63]
    ds_read_b64_tr_b16 v[112:113], v13 offset:6144
    ds_read_b64_tr_b16 v[114:115], v13 offset:7168
    v_mfma_f32_32x32x16_bf16 v[32:47], v[124:127], v[164:167], v[32:47]
    ds_read_b64_tr_b16 v[116:117], v12 offset:6144
    ds_read_b64_tr_b16 v[118:119], v12 offset:7168
    s_waitcnt lgkmcnt(4)
    v_mfma_f32_32x32x16_bf16 v[48:63], v[128:131], v[168:171], v[48:63]
    ds_read_b64_tr_b16 v[120:121], v13 offset:8192
    ds_read_b64_tr_b16 v[122:123], v13 offset:9216
    v_mfma_f32_32x32x16_bf16 v[32:47], v[132:135], v[168:171], v[32:47]
    ds_read_b64_tr_b16 v[124:125], v12 offset:8192
    ds_read_b64_tr_b16 v[126:127], v12 offset:9216
    s_waitcnt lgkmcnt(4)
    v_mfma_f32_32x32x16_bf16 v[48:63], v[112:115], v[172:175], v[48:63]
    ds_read_b64_tr_b16 v[128:129], v13 offset:10240
    ds_read_b64_tr_b16 v[130:131], v13 offset:11264
    v_mfma_f32_32x32x16_bf16 v[32:47], v[116:119], v[172:175], v[32:47]
    ds_read_b64_tr_b16 v[132:133], v12 offset:10240
    ds_read_b64_tr_b16 v[134:135], v12 offset:11264
    s_waitcnt lgkmcnt(4)
    v_mfma_f32_32x32x16_bf16 v[48:63], v[120:123], v[176:179], v[48:63]
    ds_read_b64_tr_b16 v[112:113], v13 offset:12288
    ds_read_b64_tr_b16 v[114:115], v13 offset:13312
    v_mfma_f32_32x32x16_bf16 v[32:47], v[124:127], v[176:179], v[32:47]
    ds_read_b64_tr_b16 v[116:117], v12 offset:12288
    ds_read_b64_tr_b16 v[118:119], v12 offset:13312
    s_waitcnt lgkmcnt(4)
    v_mfma_f32_32x32x16_bf16 v[48:63], v[128:131], v[180:183], v[48:63]
    s_barrier
    ds_read_b64_tr_b16 v[120:121], v13 offset:14336
    ds_read_b64_tr_b16 v[122:123], v13 offset:15360
    v_mfma_f32_32x32x16_bf16 v[32:47], v[132:135], v[180:183], v[32:47]
    ds_read_b64_tr_b16 v[124:125], v12 offset:14336
    ds_read_b64_tr_b16 v[126:127], v12 offset:15360
    s_waitcnt lgkmcnt(4)
    v_mfma_f32_32x32x16_bf16 v[48:63], v[112:115], v[184:187], v[48:63]
    ds_read_b64_tr_b16 v[128:129], v13 offset:16384
    ds_read_b64_tr_b16 v[130:131], v13 offset:17408
    v_mfma_f32_32x32x16_bf16 v[32:47], v[116:119], v[184:187], v[32:47]
    ds_read_b64_tr_b16 v[132:133], v12 offset:16384
    ds_read_b64_tr_b16 v[134:135], v12 offset:17408
    s_waitcnt lgkmcnt(4)
    v_mfma_f32_32x32x16_bf16 v[48:63], v[120:123], v[188:191], v[48:63]
    ds_read_b64_tr_b16 v[112:113], v13 offset:18432
    ds_read_b64_tr_b16 v[114:115], v13 offset:19456
    v_mfma_f32_32x32x16_bf16 v[32:47], v[124:127], v[188:191], v[32:47]
    ds_read_b64_tr_b16 v[116:117], v12 offset:18432
    ds_read_b64_tr_b16 v[118:119], v12 offset:19456
    s_waitcnt lgkmcnt(4)
    v_mfma_f32_32x32x16_bf16 v[48:63], v[128:131], v[192:195], v[48:63]
    ds_read_b64_tr_b16 v[120:121], v13 offset:20480
    ds_read_b64_tr_b16 v[122:123], v13 offset:21504
    v_mfma_f32_32x32x16_bf16 v[32:47], v[132:135], v[192:195], v[32:47]
    ds_read_b64_tr_b16 v[124:125], v12 offset:20480
    ds_read_b64_tr_b16 v[126:127], v12 offset:21504
    s_waitcnt lgkmcnt(4)
    v_mfma_f32_32x32x16_bf16 v[48:63], v[112:115], v[196:199], v[48:63]
    s_barrier
    ds_read_b64_tr_b16 v[128:129], v13 offset:22528
    ds_read_b64_tr_b16 v[130:131], v13 offset:23552
    v_mfma_f32_32x32x16_bf16 v[32:47], v[116:119], v[196:199], v[32:47]
    ds_read_b64_tr_b16 v[132:133], v12 offset:22528
    ds_read_b64_tr_b16 v[134:135], v12 offset:23552
    s_waitcnt lgkmcnt(4)
    v_mfma_f32_32x32x16_bf16 v[48:63], v[120:123], v[200:203], v[48:63]
    ds_read_b64_tr_b16 v[112:113], v13 offset:24576
    ds_read_b64_tr_b16 v[114:115], v13 offset:25600
    v_mfma_f32_32x32x16_bf16 v[32:47], v[124:127], v[200:203], v[32:47]
    ds_read_b64_tr_b16 v[116:117], v12 offset:24576
    ds_read_b64_tr_b16 v[118:119], v12 offset:25600
    s_waitcnt lgkmcnt(4)
    v_mfma_f32_32x32x16_bf16 v[48:63], v[128:131], v[204:207], v[48:63]
    ds_read_b64_tr_b16 v[120:121], v13 offset:26624
    ds_read_b64_tr_b16 v[122:123], v13 offset:27648
    v_mfma_f32_32x32x16_bf16 v[32:47], v[132:135], v[204:207], v[32:47]
    ds_read_b64_tr_b16 v[124:125], v12 offset:26624
    ds_read_b64_tr_b16 v[126:127], v12 offset:27648
    s_waitcnt lgkmcnt(4)
    v_mfma_f32_32x32x16_bf16 v[48:63], v[112:115], v[208:211], v[48:63]
    s_barrier
    ds_read_b64_tr_b16 v[128:129], v13 offset:28672
    ds_read_b64_tr_b16 v[130:131], v13 offset:29696
    v_mfma_f32_32x32x16_bf16 v[32:47], v[116:119], v[208:211], v[32:47]
    ds_read_b64_tr_b16 v[132:133], v12 offset:28672
    ds_read_b64_tr_b16 v[134:135], v12 offset:29696
    s_waitcnt lgkmcnt(4)
    v_mfma_f32_32x32x16_bf16 v[48:63], v[120:123], v[212:215], v[48:63]
    buffer_load_dwordx2 v[16:17], v249, s[8:11], 0 offen sc1
    ds_read_b64_tr_b16 v[112:113], v13 offset:30720
    ds_read_b64_tr_b16 v[114:115], v13 offset:31744
    v_mfma_f32_32x32x16_bf16 v[32:47], v[124:127], v[212:215], v[32:47]
    ds_read_b64_tr_b16 v[116:117], v12 offset:30720
    ds_read_b64_tr_b16 v[118:119], v12 offset:31744
    s_waitcnt lgkmcnt(4)
    v_mfma_f32_32x32x16_bf16 v[48:63], v[128:131], v[216:219], v[48:63]
    ds_read_b64_tr_b16 v[120:121], v13 offset:32768
    ds_read_b64_tr_b16 v[122:123], v13 offset:33792
    v_mfma_f32_32x32x16_bf16 v[32:47], v[132:135], v[216:219], v[32:47]
    ds_read_b64_tr_b16 v[124:125], v12 offset:32768
    ds_read_b64_tr_b16 v[126:127], v12 offset:33792
    s_waitcnt lgkmcnt(4)
    v_mfma_f32_32x32x16_bf16 v[48:63], v[112:115], v[220:223], v[48:63]
    s_barrier
    s_barrier
    ds_read_b64_tr_b16 v[128:129], v13 offset:34816
    ds_read_b64_tr_b16 v[130:131], v13 offset:35840
    v_mfma_f32_32x32x16_bf16 v[32:47], v[116:119], v[220:223], v[32:47]
    ds_read_b64_tr_b16 v[132:133], v12 offset:34816
    ds_read_b64_tr_b16 v[134:135], v12 offset:35840
    s_waitcnt lgkmcnt(4)
    v_mfma_f32_32x32x16_bf16 v[48:63], v[120:123], v[224:227], v[48:63]
    ds_read_b64_tr_b16 v[112:113], v13 offset:36864
    ds_read_b64_tr_b16 v[114:115], v13 offset:37888
    v_mfma_f32_32x32x16_bf16 v[32:47], v[124:127], v[224:227], v[32:47]
    ds_read_b64_tr_b16 v[116:117], v12 offset:36864
    ds_read_b64_tr_b16 v[118:119], v12 offset:37888
    s_waitcnt lgkmcnt(4)
    v_mfma_f32_32x32x16_bf16 v[48:63], v[128:131], v[228:231], v[48:63]
    ds_read_b64_tr_b16 v[120:121], v13 offset:38912
    ds_read_b64_tr_b16 v[122:123], v13 offset:39936
    v_mfma_f32_32x32x16_bf16 v[32:47], v[132:135], v[228:231], v[32:47]
    ds_read_b64_tr_b16 v[124:125], v12 offset:38912
    ds_read_b64_tr_b16 v[126:127], v12 offset:39936
    s_waitcnt lgkmcnt(4)
    v_mfma_f32_32x32x16_bf16 v[48:63], v[112:115], v[232:235], v[48:63]
    v_mfma_f32_32x32x16_bf16 v[32:47], v[116:119], v[232:235], v[32:47]
    s_waitcnt lgkmcnt(0)
    v_mfma_f32_32x32x16_bf16 v[48:63], v[120:123], v[236:239], v[48:63]
    v_mfma_f32_32x32x16_bf16 v[32:47], v[124:127], v[236:239], v[32:47]

    s_add_u32 s58, s72, 8
    s_addc_u32 s59, s73, 0
    s_mov_b32 s62, 0
    s_waitcnt vmcnt(0)
    s_and_b32 s60, s59, 0x0fffffff
    s_lshl_b32 s61, s35, 28
    s_xor_b32 s61, s59, s61
L_hello:
    v_and_b32 v1, 0x0fffffff, v17
    v_cmp_eq_u32 vcc, s58, v16
    v_cmp_eq_u32 s[78:79], s60, v1
    s_and_b64 vcc, vcc, s[78:79]
    s_cmp_eq_u64 vcc, -1
    s_cbranch_scc1 L_hello_ok
    s_add_u32 s62, s62, 1
    s_cmp_gt_u32 s62, 1048576
    s_cbranch_scc1 L_end
    buffer_load_dwordx2 v[16:17], v249, s[8:11], 0 offen sc1
    s_waitcnt vmcnt(0)
    s_branch L_hello
L_hello_ok:
    v_cmp_eq_u32 vcc, s61, v17
    s_cmp_eq_u64 vcc, -1
    s_cselect_b32 s36, 1, 0
    s_branch L_tail

L_layer2:
    buffer_load_dwordx4 v[136:139], v6, s[8:11], s37 offen offset:0 sc1
    ds_read_b64_tr_b16 v[112:113], v11 offset:0
    ds_read_b64_tr_b16 v[114:115], v11 offset:1024
    ds_read_b64_tr_b16 v[116:117], v10 offset:0
    ds_read_b64_tr_b16 v[118:119], v10 offset:1024
    buffer_load_dwordx4 v[140:143], v6, s[8:11], s37 offen offset:1024 sc1
    ds_read_b64_tr_b16 v[120:121], v11 offset:2048
    ds_read_b64_tr_b16 v[122:123], v11 offset:3072
    ds_read_b64_tr_b16 v[124:125], v10 offset:2048
    ds_read_b64_tr_b16 v[126:127], v10 offset:3072
    v_lshlrev_b32 v32, 16, v240
    v_and_b32 v33, 0xffff0000, v240
    v_lshlrev_b32 v34, 16, v241
    v_and_b32 v35, 0xffff0000, v241
    buffer_load_dwordx4 v[144:147], v6, s[8:11], s37 offen offset:2048 sc1
    v_lshlrev_b32 v36, 16, v242
    v_and_b32 v37, 0xffff0000, v242
    v_lshlrev_b32 v38, 16, v243
    v_and_b32 v39, 0xffff0000, v243
    v_lshlrev_b32 v40, 16, v244
    v_and_b32 v41, 0xffff0000, v244
    buffer_load_dwordx4 v[148:151], v6, s[8:11], s37 offen offset:3072 sc1
    v_lshlrev_b32 v42, 16, v245
    v_and_b32 v43, 0xffff0000, v245
    v_lshlrev_b32 v44, 16, v246
    v_and_b32 v45, 0xffff0000, v246
    v_lshlrev_b32 v46, 16, v247
    v_and_b32 v47, 0xffff0000, v247
    buffer_load_dwordx4 v[152:155], v7, s[8:11], s37 offen offset:0 sc1
    s_waitcnt vmcnt(4) lgkmcnt(4)
    v_mfma_f32_32x32x16_bf16 v[48:63], v[112:115], v[136:139], 0
    buffer_load_dwordx4 v[156:159], v7, s[8:11], s37 offen offset:1024 sc1
    ds_read_b64_tr_b16 v[128:129], v11 offset:4096
    ds_read_b64_tr_b16 v[130:131], v11 offset:5120
    v_mfma_f32_32x32x16_bf16 v[32:47], v[116:119], v[136:139], v[32:47]
    ds_read_b64_tr_b16 v[132:133], v10 offset:4096
    ds_read_b64_tr_b16 v[134:135], v10 offset:5120
    s_waitcnt vmcnt(4) lgkmcnt(4)
    v_mfma_f32_32x32x16_bf16 v[48:63], v[120:123], v[140:143], v[48:63]
    s_add_u32 s74, s74, 1
    s_addc_u32 s75, s75, 0
    buffer_load_dwordx4 v[160:163], v7, s[8:11], s37 offen offset:2048 sc1
    ds_read_b64_tr_b16 v[112:113], v11 offset:6144
    ds_read_b64_tr_b16 v[114:115], v11 offset:7168
    v_mfma_f32_32x32x16_bf16 v[32:47], v[124:127], v[140:143], v[32:47]
    ds_read_b64_tr_b16 v[116:117], v10 offset:6144
    ds_read_b64_tr_b16 v[118:119], v10 offset:7168
    s_waitcnt vmcnt(4) lgkmcnt(4)
    v_mfma_f32_32x32x16_bf16 v[48:63], v[128:131], v[144:147], v[48:63]
    s_add_u32 s76, s76, 1
    s_addc_u32 s77, s77, 0
    buffer_load_dwordx4 v[164:167], v7, s[8:11], s37 offen offset:3072 sc1
    ds_read_b64_tr_b16 v[120:121], v11 offset:8192
    ds_read_b64_tr_b16 v[122:123], v11 offset:9216
    v_mfma_f32_32x32x16_bf16 v[32:47], v[132:135], v[144:147], v[32:47]
    ds_read_b64_tr_b16 v[124:125], v10 offset:8192
    ds_read_b64_tr_b16 v[126:127], v10 offset:9216
    s_waitcnt vmcnt(4) lgkmcnt(4)
    v_mfma_f32_32x32x16_bf16 v[48:63], v[112:115], v[148:151], v[48:63]
    buffer_load_dwordx4 v[168:171], v8, s[8:11], s37 offen offset:0 sc1
    ds_read_b64_tr_b16 v[128:129], v11 offset:10240
    ds_read_b64_tr_b16 v[130:131], v11 offset:11264
    v_mfma_f32_32x32x16_bf16 v[32:47], v[116:119], v[148:151], v[32:47]
    ds_read_b64_tr_b16 v[132:133], v10 offset:10240
    ds_read_b64_tr_b16 v[134:135], v10 offset:11264
    s_waitcnt vmcnt(4) lgkmcnt(4)
    v_mfma_f32_32x32x16_bf16 v[48:63], v[120:123], v[152:155], v[48:63]
    s_barrier
    buffer_load_dwordx4 v[172:175], v8, s[8:11], s37 offen offset:1024 sc1
    ds_read_b64_tr_b16 v[112:113], v13 offset:0
    ds_read_b64_tr_b16 v[114:115], v13 offset:1024
    v_mfma_f32_32x32x16_bf16 v[32:47], v[124:127], v[152:155], v[32:47]
    ds_read_b64_tr_b16 v[116:117], v12 offset:0
    ds_read_b64_tr_b16 v[118:119], v12 offset:1024
    s_waitcnt vmcnt(4) lgkmcnt(4)
    v_mfma_f32_32x32x16_bf16 v[48:63], v[128:131], v[156:159], v[48:63]
    buffer_load_dwordx4 v[176:179], v8, s[8:11], s37 offen offset:2048 sc1
    ds_read_b64_tr_b16 v[120:121], v13 offset:2048
    ds_read_b64_tr_b16 v[122:123], v13 offset:3072
    v_mfma_f32_32x32x16_bf16 v[32:47], v[132:135], v[156:159], v[32:47]
    ds_read_b64_tr_b16 v[124:125], v12 offset:2048
    ds_read_b64_tr_b16 v[126:127], v12 offset:3072
    s_waitcnt vmcnt(4) lgkmcnt(4)
    v_mfma_f32_32x32x16_bf16 v[48:63], v[112:115], v[160:163], v[48:63]
    buffer_load_dwordx4 v[180:183], v8, s[8:11], s37 offen offset:3072 sc1
    ds_read_b64_tr_b16 v[128:129], v13 offset:4096
    ds_read_b64_tr_b16 v[130:131], v13 offset:5120
    v_mfma_f32_32x32x16_bf16 v[32:47], v[116:119], v[160:163], v[32:47]
    ds_read_b64_tr_b16 v[132:133], v12 offset:4096
    ds_read_b64_tr_b16 v[134:135], v12 offset:5120
    s_waitcnt vmcnt(4) lgkmcnt(4)
    v_mfma_f32_32x32x16_bf16 v[48:63], v[120:123], v[164:167], v[48:63]
    buffer_load_dwordx4 v[184:187], v9, s[8:11], s37 offen offset:0 sc1
    ds_read_b64_tr_b16 v[112:113], v13 offset:6144
    ds_read_b64_tr_b16 v[114:115], v13 offset:7168
    v_mfma_f32_32x32x16_bf16 v[32:47], v[124:127], v[164:167], v[32:47]
    ds_read_b64_tr_b16 v[116:117], v12 offset:6144
    ds_read_b64_tr_b16 v[118:119], v12 offset:7168
    s_waitcnt vmcnt(4) lgkmcnt(4)
    v_mfma_f32_32x32x16_bf16 v[48:63], v[128:131], v[168:171], v[48:63]
    buffer_load_dwordx4 v[188:191], v6, s[8:11], s38 offen offset:0 sc1
    ds_read_b64_tr_b16 v[120:121], v13 offset:8192
    ds_read_b64_tr_b16 v[122:123], v13 offset:9216
    v_mfma_f32_32x32x16_bf16 v[32:47], v[132:135], v[168:171], v[32:47]
    ds_read_b64_tr_b16 v[124:125], v12 offset:8192
    ds_read_b64_tr_b16 v[126:127], v12 offset:9216
    s_waitcnt vmcnt(4) lgkmcnt(4)
    v_mfma_f32_32x32x16_bf16 v[48:63], v[112:115], v[172:175], v[48:63]
    buffer_load_dwordx4 v[192:195], v6, s[8:11], s38 offen offset:1024 sc1
    ds_read_b64_tr_b16 v[128:129], v13 offset:10240
    ds_read_b64_tr_b16 v[130:131], v13 offset:11264
    v_mfma_f32_32x32x16_bf16 v[32:47], v[116:119], v[172:175], v[32:47]
    ds_read_b64_tr_b16 v[132:133], v12 offset:10240
    ds_read_b64_tr_b16 v[134:135], v12 offset:11264
    s_waitcnt vmcnt(4) lgkmcnt(4)
    v_mfma_f32_32x32x16_bf16 v[48:63], v[120:123], v[176:179], v[48:63]
    buffer_load_dwordx4 v[196:199], v6, s[8:11], s38 offen offset:2048 sc1
    ds_read_b64_tr_b16 v[112:113], v13 offset:12288
    ds_read_b64_tr_b16 v[114:115], v13 offset:13312
    v_mfma_f32_32x32x16_bf16 v[32:47], v[124:127], v[176:179], v[32:47]
    ds_read_b64_tr_b16 v[116:117], v12 offset:12288
    ds_read_b64_tr_b16 v[118:119], v12 offset:13312
    s_waitcnt vmcnt(4) lgkmcnt(4)
    v_mfma_f32_32x32x16_bf16 v[48:63], v[128:131], v[180:183], v[48:63]
    buffer_load_dwordx4 v[200:203], v6, s[8:11], s38 offen offset:3072 sc1
    ds_read_b64_tr_b16 v[120:121], v13 offset:14336
    ds_read_b64_tr_b16 v[122:123], v13 offset:15360
    v_mfma_f32_32x32x16_bf16 v[32:47], v[132:135], v[180:183], v[32:47]
    ds_read_b64_tr_b16 v[124:125], v12 offset:14336
    ds_read_b64_tr_b16 v[126:127], v12 offset:15360
    s_waitcnt vmcnt(4) lgkmcnt(4)
    v_mfma_f32_32x32x16_bf16 v[48:63], v[112:115], v[184:187], v[48:63]
    buffer_load_dwordx4 v[204:207], v7, s[8:11], s38 offen offset:0 sc1
    ds_read_b64_tr_b16 v[128:129], v13 offset:16384
    ds_read_b64_tr_b16 v[130:131], v13 offset:17408
    v_mfma_f32_32x32x16_bf16 v[32:47], v[116:119], v[184:187], v[32:47]
    ds_read_b64_tr_b16 v[132:133], v12 offset:16384
    ds_read_b64_tr_b16 v[134:135], v12 offset:17408
    s_waitcnt vmcnt(4) lgkmcnt(4)
    v_mfma_f32_32x32x16_bf16 v[48:63], v[120:123], v[188:191], v[48:63]
    buffer_load_dwordx4 v[208:211], v7, s[8:11], s38 offen offset:1024 sc1
    ds_read_b64_tr_b16 v[112:113], v13 offset:18432
    ds_read_b64_tr_b16 v[114:115], v13 offset:19456
    v_mfma_f32_32x32x16_bf16 v[32:47], v[124:127], v[188:191], v[32:47]
    ds_read_b64_tr_b16 v[116:117], v12 offset:18432
    ds_read_b64_tr_b16 v[118:119], v12 offset:19456
    s_waitcnt vmcnt(4) lgkmcnt(4)
    v_mfma_f32_32x32x16_bf16 v[48:63], v[128:131], v[192:195], v[48:63]
    buffer_load_dwordx4 v[212:215], v7, s[8:11], s38 offen offset:2048 sc1
    ds_read_b64_tr_b16 v[120:121], v13 offset:20480
    ds_read_b64_tr_b16 v[122:123], v13 offset:21504
    v_mfma_f32_32x32x16_bf16 v[32:47], v[132:135], v[192:195], v[32:47]
    ds_read_b64_tr_b16 v[124:125], v12 offset:20480
    ds_read_b64_tr_b16 v[126:127], v12 offset:21504
    s_waitcnt vmcnt(4) lgkmcnt(4)
    v_mfma_f32_32x32x16_bf16 v[48:63], v[112:115], v[196:199], v[48:63]
    buffer_load_dwordx4 v[216:219], v7, s[8:11], s38 offen offset:3072 sc1
    ds_read_b64_tr_b16 v[128:129], v13 offset:22528
    ds_read_b64_tr_b16 v[130:131], v13 offset:23552
    v_mfma_f32_32x32x16_bf16 v[32:47], v[116:119], v[196:199], v[32:47]
    ds_read_b64_tr_b16 v[132:133], v12 offset:22528
    ds_read_b64_tr_b16 v[134:135], v12 offset:23552
    s_waitcnt vmcnt(4) lgkmcnt(4)
    v_mfma_f32_32x32x16_bf16 v[48:63], v[120:123], v[200:203], v[48:63]
    buffer_load_dwordx4 v[220:223], v8, s[8:11], s38 offen offset:0 sc1
    ds_read_b64_tr_b16 v[112:113], v13 offset:24576
    ds_read_b64_tr_b16 v[114:115], v13 offset:25600
    v_mfma_f32_32x32x16_bf16 v[32:47], v[124:127], v[200:203], v[32:47]
    ds_read_b64_tr_b16 v[116:117], v12 offset:24576
    ds_read_b64_tr_b16 v[118:119], v12 offset:25600
    s_waitcnt vmcnt(4) lgkmcnt(4)
    v_mfma_f32_32x32x16_bf16 v[48:63], v[128:131], v[204:207], v[48:63]
    buffer_load_dwordx4 v[224:227], v8, s[8:11], s38 offen offset:1024 sc1
    ds_read_b64_tr_b16 v[120:121], v13 offset:26624
    ds_read_b64_tr_b16 v[122:123], v13 offset:27648
    v_mfma_f32_32x32x16_bf16 v[32:47], v[132:135], v[204:207], v[32:47]
    ds_read_b64_tr_b16 v[124:125], v12 offset:26624
    ds_read_b64_tr_b16 v[126:127], v12 offset:27648
    s_waitcnt vmcnt(4) lgkmcnt(4)
    v_mfma_f32_32x32x16_bf16 v[48:63], v[112:115], v[208:211], v[48:63]
    buffer_load_dwordx4 v[228:231], v8, s[8:11], s38 offen offset:2048 sc1
    ds_read_b64_tr_b16 v[128:129], v13 offset:28672
    ds_read_b64_tr_b16 v[130:131], v13 offset:29696
    v_mfma_f32_32x32x16_bf16 v[32:47], v[116:119], v[208:211], v[32:47]
    ds_read_b64_tr_b16 v[132:133], v12 offset:28672
    ds_read_b64_tr_b16 v[134:135], v12 offset:29696
    s_waitcnt vmcnt(4) lgkmcnt(4)
    v_mfma_f32_32x32x16_bf16 v[48:63], v[120:123], v[212:215], v[48:63]
    buffer_load_dwordx4 v[232:235], v8, s[8:11], s38 offen offset:3072 sc1
    ds_read_b64_tr_b16 v[112:113], v13 offset:30720
    ds_read_b64_tr_b16 v[114:115], v13 offset:31744
    v_mfma_f32_32x32x16_bf16 v[32:47], v[124:127], v[212:215], v[32:47]
    ds_read_b64_tr_b16 v[116:117], v12 offset:30720
    ds_read_b64_tr_b16 v[118:119], v12 offset:31744
    s_waitcnt vmcnt(4) lgkmcnt(4)
    v_mfma_f32_32x32x16_bf16 v[48:63], v[128:131], v[216:219], v[48:63]
    buffer_load_dwordx4 v[236:239], v9, s[8:11], s38 offen offset:0 sc1
    ds_read_b64_tr_b16 v[120:121], v13 offset:32768
    ds_read_b64_tr_b16 v[122:123], v13 offset:33792
    v_mfma_f32_32x32x16_bf16 v[32:47], v[132:135], v[216:219], v[32:47]
    ds_read_b64_tr_b16 v[124:125], v12 offset:32768
    ds_read_b64_tr_b16 v[126:127], v12 offset:33792
    s_waitcnt vmcnt(4) lgkmcnt(4)
    v_mfma_f32_32x32x16_bf16 v[48:63], v[112:115], v[220:223], v[48:63]
    s_barrier
    ds_read_b64_tr_b16 v[128:129], v13 offset:34816
    ds_read_b64_tr_b16 v[130:131], v13 offset:35840
    v_mfma_f32_32x32x16_bf16 v[32:47], v[116:119], v[220:223], v[32:47]
    ds_read_b64_tr_b16 v[132:133], v12 offset:34816
    ds_read_b64_tr_b16 v[134:135], v12 offset:35840
    s_waitcnt vmcnt(3) lgkmcnt(4)
    v_mfma_f32_32x32x16_bf16 v[48:63], v[120:123], v[224:227], v[48:63]
    ds_read_b64_tr_b16 v[112:113], v13 offset:36864
    ds_read_b64_tr_b16 v[114:115], v13 offset:37888
    v_mfma_f32_32x32x16_bf16 v[32:47], v[124:127], v[224:227], v[32:47]
    ds_read_b64_tr_b16 v[116:117], v12 offset:36864
    ds_read_b64_tr_b16 v[118:119], v12 offset:37888
    s_waitcnt vmcnt(2) lgkmcnt(4)
    v_mfma_f32_32x32x16_bf16 v[48:63], v[128:131], v[228:231], v[48:63]
    ds_read_b64_tr_b16 v[120:121], v13 offset:38912
    ds_read_b64_tr_b16 v[122:123], v13 offset:39936
    v_mfma_f32_32x32x16_bf16 v[32:47], v[132:135], v[228:231], v[32:47]
    ds_read_b64_tr_b16 v[124:125], v12 offset:38912
    ds_read_b64_tr_b16 v[126:127], v12 offset:39936
    s_waitcnt vmcnt(1) lgkmcnt(4)
    v_mfma_f32_32x32x16_bf16 v[48:63], v[112:115], v[232:235], v[48:63]
    v_mfma_f32_32x32x16_bf16 v[32:47], v[116:119], v[232:235], v[32:47]
    s_waitcnt vmcnt(0) lgkmcnt(0)
    v_mfma_f32_32x32x16_bf16 v[48:63], v[120:123], v[236:239], v[48:63]
    v_mfma_f32_32x32x16_bf16 v[32:47], v[124:127], v[236:239], v[32:47]
L_tail:
    v_mov_b32 v250, s74
    v_mov_b32 v251, s75
    s_nop 8
    ds_write_b128 v20, v[48:51] offset:0
    ds_write_b128 v20, v[52:55] offset:1024
    ds_write_b128 v20, v[56:59] offset:2048
    ds_write_b128 v20, v[60:63] offset:3072
    s_nop 0
    v_pk_fma_f32 v[32:33], v[80:81], v[32:33], v[96:97]
    v_pk_fma_f32 v[34:35], v[82:83], v[34:35], v[98:99]
    v_pk_fma_f32 v[36:37], v[84:85], v[36:37], v[100:101]
    v_pk_fma_f32 v[38:39], v[86:87], v[38:39], v[102:103]
    v_pk_fma_f32 v[40:41], v[88:89], v[40:41], v[104:105]
    v_pk_fma_f32 v[42:43], v[90:91], v[42:43], v[106:107]
    v_pk_fma_f32 v[44:45], v[92:93], v[44:45], v[108:109]
    v_pk_fma_f32 v[46:47], v[94:95], v[46:47], v[110:111]
    s_waitcnt lgkmcnt(0)
    s_barrier
    ds_read_b128 v[64:67], v21 offset:0
    ds_read_b128 v[68:71], v21 offset:1024
    ds_read_b128 v[72:75], v21 offset:2048
    ds_read_b128 v[76:79], v21 offset:3072

    s_cmp_eq_u32 s34, 5
    s_cbranch_scc1 L_final
    s_cmp_eq_u32 s36, 0
    s_cbranch_scc1 L_st_slow

    s_waitcnt lgkmcnt(3)
    v_pk_fma_f32 v[32:33], v[80:81], v[64:65], v[32:33]
    v_pk_fma_f32 v[34:35], v[82:83], v[66:67], v[34:35]
    v_cvt_pk_bf16_f32 v24, v32, v33
    v_cvt_pk_bf16_f32 v25, v34, v35
    s_waitcnt lgkmcnt(2)
    v_pk_fma_f32 v[36:37], v[84:85], v[68:69], v[36:37]
    v_pk_fma_f32 v[38:39], v[86:87], v[70:71], v[38:39]
    v_cvt_pk_bf16_f32 v26, v36, v37
    v_cvt_pk_bf16_f32 v27, v38, v39
    buffer_store_dwordx4 v[24:27], v6, s[8:11], s39 offen
    s_waitcnt lgkmcnt(1)
    v_pk_fma_f32 v[40:41], v[88:89], v[72:73], v[40:41]
    v_pk_fma_f32 v[42:43], v[90:91], v[74:75], v[42:43]
    v_cvt_pk_bf16_f32 v28, v40, v41
    v_cvt_pk_bf16_f32 v29, v42, v43
    s_waitcnt lgkmcnt(0)
    v_pk_fma_f32 v[44:45], v[92:93], v[76:77], v[44:45]
    v_pk_fma_f32 v[46:47], v[94:95], v[78:79], v[46:47]
    v_cvt_pk_bf16_f32 v30, v44, v45
    v_cvt_pk_bf16_f32 v31, v46, v47
    buffer_store_dwordx4 v[28:31], v6, s[8:11], s39 offen offset:1024
    s_barrier
    s_load_dwordx16 s[84:99], s[48:49], 0
    s_add_u32 s48, s48, 1664
    s_addc_u32 s49, s49, 0
    v_lshlrev_b32 v96, 16, v24
    v_and_b32 v97, 0xffff0000, v24
    v_lshlrev_b32 v98, 16, v25
    v_and_b32 v99, 0xffff0000, v25
    v_lshlrev_b32 v100, 16, v26
    v_and_b32 v101, 0xffff0000, v26
    v_lshlrev_b32 v102, 16, v27
    v_and_b32 v103, 0xffff0000, v27
    v_lshlrev_b32 v104, 16, v28
    v_and_b32 v105, 0xffff0000, v28
    v_lshlrev_b32 v106, 16, v29
    v_and_b32 v107, 0xffff0000, v29
    v_lshlrev_b32 v108, 16, v30
    v_and_b32 v109, 0xffff0000, v30
    v_lshlrev_b32 v110, 16, v31
    v_and_b32 v111, 0xffff0000, v31

    s_waitcnt vmcnt(0)
    buffer_store_dwordx2 v[250:251], off, s[8:11], s56
    s_branch L_st_done
L_st_slow:

    s_waitcnt lgkmcnt(3)
    v_pk_fma_f32 v[32:33], v[80:81], v[64:65], v[32:33]
    v_pk_fma_f32 v[34:35], v[82:83], v[66:67], v[34:35]
    v_cvt_pk_bf16_f32 v24, v32, v33
    v_cvt_pk_bf16_f32 v25, v34, v35
    s_waitcnt lgkmcnt(2)
    v_pk_fma_f32 v[36:37], v[84:85], v[68:69], v[36:37]
    v_pk_fma_f32 v[38:39], v[86:87], v[70:71], v[38:39]
    v_cvt_pk_bf16_f32 v26, v36, v37
    v_cvt_pk_bf16_f32 v27, v38, v39
    s_waitcnt lgkmcnt(1)
    v_pk_fma_f32 v[40:41], v[88:89], v[72:73], v[40:41]
    v_pk_fma_f32 v[42:43], v[90:91], v[74:75], v[42:43]
    v_cvt_pk_bf16_f32 v28, v40, v41
    v_cvt_pk_bf16_f32 v29, v42, v43
    s_waitcnt lgkmcnt(0)
    v_pk_fma_f32 v[44:45], v[92:93], v[76:77], v[44:45]
    v_pk_fma_f32 v[46:47], v[94:95], v[78:79], v[46:47]
    v_cvt_pk_bf16_f32 v30, v44, v45
    v_cvt_pk_bf16_f32 v31, v46, v47

    buffer_store_dwordx4 v[24:27], v6, s[8:11], s39 offen sc1
    buffer_store_dwordx4 v[28:31], v6, s[8:11], s39 offen offset:1024 sc1

    s_barrier
    s_load_dwordx16 s[84:99], s[48:49], 0
    s_add_u32 s48, s48, 1664
    s_addc_u32 s49, s49, 0
    v_lshlrev_b32 v96, 16, v24
    v_and_b32 v97, 0xffff0000, v24
    v_lshlrev_b32 v98, 16, v25
    v_and_b32 v99, 0xffff0000, v25
    v_lshlrev_b32 v100, 16, v26
    v_and_b32 v101, 0xffff0000, v26
    v_lshlrev_b32 v102, 16, v27
    v_and_b32 v103, 0xffff0000, v27
    v_lshlrev_b32 v104, 16, v28
    v_and_b32 v105, 0xffff0000, v28
    v_lshlrev_b32 v106, 16, v29
    v_and_b32 v107, 0xffff0000, v29
    v_lshlrev_b32 v108, 16, v30
    v_and_b32 v109, 0xffff0000, v30
    v_lshlrev_b32 v110, 16, v31
    v_and_b32 v111, 0xffff0000, v31

    s_waitcnt vmcnt(0)
    buffer_store_dwordx2 v[250:251], off, s[8:11], s56 sc1
L_st_done:

    s_cmp_eq_u32 s31, 0
    s_cbranch_scc0 L_nopoll1

    buffer_load_dwordx2 v[16:17], v15, s[8:11], 0 offen sc1
L_nopoll1:
    s_barrier

    s_or_b32 s58, s29, s31
    s_cmp_eq_u32 s58, 0
    s_cbranch_scc0 L_noprog
    s_add_u32 s58, s71, 3072
    buffer_store_dwordx2 v[250:251], off, s[8:11], s58
L_noprog:

    s_add_u32 s34, s34, 1
    s_cmp_eq_u32 s34, 1
    s_cbranch_scc1 L_keep_xa
    s_add_u32 s37, s37, s70
    s_add_u32 s38, s38, s70
    s_sub_u32 s70, 0, s70
L_keep_xa:
    s_add_u32 s39, s39, s57
    s_sub_u32 s57, 0, s57
    s_add_u32 s52, s52, 1384448
    s_sub_u32 s53, s53, s54
    v_add_u32 v10, s54, v10
    v_add_u32 v11, s54, v11
    s_sub_u32 s54, 0, s54
    s_mov_b32 s62, 0

    s_waitcnt lgkmcnt(0)
    s_mov_b32 exec_hi, 0
    v_mov_b32 v240, s84
    v_mov_b32 v241, s85
    v_mov_b32 v242, s88
    v_mov_b32 v243, s89
    v_mov_b32 v244, s92
    v_mov_b32 v245, s93
    v_mov_b32 v246, s96
    v_mov_b32 v247, s97
    s_mov_b32 exec_lo, 0
    s_mov_b32 exec_hi, -1
    v_mov_b32 v240, s86
    v_mov_b32 v241, s87
    v_mov_b32 v242, s90
    v_mov_b32 v243, s91
    v_mov_b32 v244, s94
    v_mov_b32 v245, s95
    v_mov_b32 v246, s98
    v_mov_b32 v247, s99
    s_mov_b64 exec, -1

    s_cmp_eq_u32 s31, 0
    s_cbranch_scc0 L_ready
L_poll:
    s_waitcnt vmcnt(0)
    v_cmp_eq_u64 vcc, s[74:75], v[16:17]
    v_cmp_eq_u64 s[78:79], s[76:77], v[16:17]
    s_or_b64 vcc, vcc, s[78:79]
    s_cmp_eq_u64 vcc, -1
    s_cbranch_scc1 L_ready
    buffer_load_dwordx2 v[16:17], v15, s[8:11], 0 offen sc1
    s_add_u32 s62, s62, 1
    s_cmp_gt_u32 s62, 1048576
    s_cbranch_scc0 L_poll
    s_endpgm

L_ready:

    s_barrier
    s_branch L_layer2
L_final:

    s_waitcnt lgkmcnt(3)
    v_pk_fma_f32 v[32:33], v[80:81], v[64:65], v[32:33]
    v_pk_fma_f32 v[34:35], v[82:83], v[66:67], v[34:35]
    v_cvt_pk_bf16_f32 v24, v32, v33
    v_cvt_pk_bf16_f32 v25, v34, v35
    s_waitcnt lgkmcnt(2)
    v_pk_fma_f32 v[36:37], v[84:85], v[68:69], v[36:37]
    v_pk_fma_f32 v[38:39], v[86:87], v[70:71], v[38:39]
    v_cvt_pk_bf16_f32 v26, v36, v37
    v_cvt_pk_bf16_f32 v27, v38, v39
    s_waitcnt lgkmcnt(1)
    v_pk_fma_f32 v[40:41], v[88:89], v[72:73], v[40:41]
    v_pk_fma_f32 v[42:43], v[90:91], v[74:75], v[42:43]
    v_cvt_pk_bf16_f32 v28, v40, v41
    v_cvt_pk_bf16_f32 v29, v42, v43
    s_waitcnt lgkmcnt(0)
    v_pk_fma_f32 v[44:45], v[92:93], v[76:77], v[44:45]
    v_pk_fma_f32 v[46:47], v[94:95], v[78:79], v[46:47]
    v_cvt_pk_bf16_f32 v30, v44, v45
    v_cvt_pk_bf16_f32 v31, v46, v47

    s_nop 1
    v_permlane32_swap_b32 v24, v26
    v_permlane32_swap_b32 v25, v27
    v_permlane32_swap_b32 v28, v30
    v_permlane32_swap_b32 v29, v31

    buffer_store_dwordx4 v[24:27], v248, s[16:19], 0 offen
    buffer_store_dwordx4 v[28:31], v248, s[16:19], 0 offen offset:32

    s_or_b32 s58, s29, s31
    s_cmp_eq_u32 s58, 0
    s_cbranch_scc0 L_noepoch
    s_add_u32 s58, s72, 16
    s_addc_u32 s59, s73, 0
    v_mov_b32 v250, s58
    v_mov_b32 v251, s59
    s_mov_b64 exec, 1
    buffer_store_dwordx2 v[250:251], off, s[8:11], s71 sc1
    s_mov_b64 exec, -1
L_noepoch:

    s_endpgm

L_helper:

    s_sub_u32 s58, s2, 208
    s_and_b32 s59, s58, 7
    s_lshr_b32 s58, s58, 3
    s_lshl_b32 s58, s58, 3
    s_add_u32 s58, s58, s31
    s_lshl_b32 s71, s59, 13
    s_add_u32 s71, s71, 3407872
    s_load_dwordx2 s[72:73], s[50:51], s71
    s_add_u32 s56, s71, 3072

    s_mul_i32 s64, s59, 212992
    s_lshl_b32 s66, s58, 13
    s_add_u32 s64, s64, s66
    v_lshlrev_b32 v19, 7, v0
    v_add_u32 v19, s64, v19
    s_cmp_lt_u32 s58, 26
    s_cselect_b32 s65, 1, 0

    s_mul_i32 s60, s59, 12

    s_add_u32 s61, s58, 0
    s_add_u32 s66, s61, s60
    s_cmp_ge_u32 s66, 96
    s_cselect_b32 s64, 96, 0
    s_sub_u32 s66, s66, s64
    s_cmp_ge_u32 s61, 96
    s_cselect_b32 s66, 104, s66

    s_lshl_b32 s66, s66, 6
    v_add_u32 v1, s66, v0
    v_mov_b32 v2, 149760
    v_cmp_le_u32 vcc, 1534, v1
    v_mov_b32 v3, 0
    v_mov_b32 v4, 149760
    v_cndmask_b32 v3, v3, v4, vcc
    v_add_u32 v2, v2, v3
    v_cmp_le_u32 vcc, 3068, v1
    v_mov_b32 v3, 0
    s_nop 0
    v_cndmask_b32 v3, v3, v4, vcc
    v_add_u32 v2, v2, v3
    v_cmp_le_u32 vcc, 4602, v1
    v_mov_b32 v3, 0
    s_nop 0
    v_cndmask_b32 v3, v3, v4, vcc
    v_add_u32 v2, v2, v3
    v_lshl_add_u32 v10, v1, 7, v2
    v_cmp_le_u32 vcc, 6136, v1
    v_mov_b32 v3, 0x7ffffff0
    s_nop 0
    v_cndmask_b32 v10, v10, v3, vcc

    s_add_u32 s61, s58, 48
    s_add_u32 s66, s61, s60
    s_cmp_ge_u32 s66, 96
    s_cselect_b32 s64, 96, 0
    s_sub_u32 s66, s66, s64
    s_cmp_ge_u32 s61, 96
    s_cselect_b32 s66, 104, s66

    s_lshl_b32 s66, s66, 6
    v_add_u32 v1, s66, v0
    v_mov_b32 v2, 149760
    v_cmp_le_u32 vcc, 1534, v1
    v_mov_b32 v3, 0
    v_mov_b32 v4, 149760
    v_cndmask_b32 v3, v3, v4, vcc
    v_add_u32 v2, v2, v3
    v_cmp_le_u32 vcc, 3068, v1
    v_mov_b32 v3, 0
    s_nop 0
    v_cndmask_b32 v3, v3, v4, vcc
    v_add_u32 v2, v2, v3
    v_cmp_le_u32 vcc, 4602, v1
    v_mov_b32 v3, 0
    s_nop 0
    v_cndmask_b32 v3, v3, v4, vcc
    v_add_u32 v2, v2, v3
    v_lshl_add_u32 v11, v1, 7, v2
    v_cmp_le_u32 vcc, 6136, v1
    v_mov_b32 v3, 0x7ffffff0
    s_nop 0
    v_cndmask_b32 v11, v11, v3, vcc

    s_mul_i32 s66, s59, 767
    s_mul_i32 s64, s58, 14
    s_add_u32 s66, s66, s64
    s_mov_b32 s64, 149760
    s_cmp_ge_u32 s66, 1534
    s_cselect_b32 s61, 149760, 0
    s_add_u32 s64, s64, s61
    s_cmp_ge_u32 s66, 3068
    s_cselect_b32 s61, 149760, 0
    s_add_u32 s64, s64, s61
    s_cmp_ge_u32 s66, 4602
    s_cselect_b32 s61, 149760, 0
    s_add_u32 s64, s64, s61
    s_lshl_b32 s66, s66, 7
    s_add_u32 s66, s66, s64
    s_add_u32 s66, s66, 1384448
    s_add_u32 s44, s42, s66
    s_addc_u32 s45, s43, 0

    v_mov_b32 v20, 0
    s_mov_b32 s34, 0
    s_mov_b32 s61, 0
    s_waitcnt lgkmcnt(0)
L_h_layer:

    s_cmp_lt_u32 s34, 2
    s_cbranch_scc1 L_h_go
    s_cmp_eq_u32 s31, 0
    s_cbranch_scc0 L_h_bar
    s_mov_b32 s62, 0
L_h_poll:
    buffer_load_dwordx2 v[16:17], v20, s[8:11], s56 offen sc1
    s_waitcnt vmcnt(0)
    v_readfirstlane_b32 s74, v16
    v_readfirstlane_b32 s75, v17
    s_sub_u32 s74, s74, s72
    s_subb_u32 s75, s75, s73
    s_cmp_eq_u32 s75, 0
    s_cselect_b32 s74, s74, 0
    s_cmp_gt_u32 s74, 6
    s_cselect_b32 s74, 0, s74
    s_add_u32 s74, s74, 1
    s_cmp_ge_u32 s74, s34
    s_cbranch_scc1 L_h_bar
    s_add_u32 s62, s62, 1
    s_cmp_lt_u32 s62, 32
    s_cbranch_scc1 L_h_poll
L_h_bar:
    s_barrier
L_h_go:

    buffer_load_dword v31, v10, s[4:7], s61 offen
    s_cmp_lt_u32 s34, 5
    s_cbranch_scc0 L_hw0
    s_waitcnt lgkmcnt(0)
    s_load_dwordx2 s[76:77], s[44:45], 60
    s_load_dwordx2 s[78:79], s[44:45], 188
    s_load_dwordx2 s[80:81], s[44:45], 316
    s_load_dwordx2 s[82:83], s[44:45], 444
    s_load_dwordx2 s[84:85], s[44:45], 572
    s_load_dwordx2 s[86:87], s[44:45], 700
    s_load_dwordx2 s[88:89], s[44:45], 828
L_hw0:
    s_waitcnt vmcnt(1)
    s_barrier
    buffer_load_dword v32, v11, s[4:7], s61 offen
    s_cmp_lt_u32 s34, 5
    s_cbranch_scc0 L_hw1
    s_waitcnt lgkmcnt(0)
    s_load_dwordx2 s[76:77], s[44:45], 956
    s_load_dwordx2 s[78:79], s[44:45], 1084
    s_load_dwordx2 s[80:81], s[44:45], 1212
    s_load_dwordx2 s[82:83], s[44:45], 1340
    s_load_dwordx2 s[84:85], s[44:45], 1468
    s_load_dwordx2 s[86:87], s[44:45], 1596
    s_load_dwordx2 s[88:89], s[44:45], 1724
L_hw1:
    s_waitcnt vmcnt(1)
    s_barrier
    s_add_u32 s44, s44, 1384448
    s_addc_u32 s45, s45, 0

    s_sub_u32 s66, s34, 0
    s_add_u32 s66, s66, 0
    s_cmp_lt_u32 s66, 2
    s_cbranch_scc0 L_hx0
    s_cmp_eq_u32 s65, 1
    s_cbranch_scc0 L_hx0
    s_cmp_eq_u32 s66, 0
    s_cselect_b32 s66, 1703936, 0
    buffer_load_dword v30, v19, s[8:11], s66 offen sc1
L_hx0:

    s_add_u32 s34, s34, 1
    s_add_u32 s61, s61, 1384448
    s_cmp_lt_u32 s34, 6
    s_cbranch_scc1 L_h_layer

    s_waitcnt vmcnt(0)
L_end:
    s_endpgm
.section .rodata,"a"
.p2align 6
.amdhsa_kernel standalone__dcn_v2_cross__recsys_kernel
  .amdhsa_next_free_vgpr 256
  .amdhsa_next_free_sgpr 102
  .amdhsa_accum_offset 256
  .amdhsa_group_segment_fixed_size 0
  .amdhsa_kernarg_size 48
  .amdhsa_user_sgpr_count 2
  .amdhsa_user_sgpr_kernarg_segment_ptr 1
  .amdhsa_system_sgpr_workgroup_id_x 1
.end_amdhsa_kernel
```
